```python
import torch

def _softmax(x, axis=-1):
    return torch.softmax(x, dim=axis)
def _gelu(x):
    return torch.nn.functional.gelu(x, approximate="tanh")
def _silu(x):
    return torch.nn.functional.silu(x)
def _sigmoid(x):
    return torch.sigmoid(x)
def _layernorm(x, axis=-1, eps=1e-5):
    m = x.mean(dim=axis, keepdim=True)
    v = x.var(dim=axis, keepdim=True, unbiased=False)
    return (x - m) / torch.sqrt(v + eps)
def _scatter_add(tgt, idx, src, axis=0):
    return tgt.clone().index_add_(axis, idx, src)
def _segment_sum(src, seg, n):
    out = torch.zeros((n,) + src.shape[1:], dtype=src.dtype)
    return out.index_add_(0, seg, src)
def _pad(x, pw):
    flat = tuple(v for pair in reversed(pw) for v in pair)
    return torch.nn.functional.pad(x, flat)

kernel_name = 'concat_heads__gqa_block_cached__sliding_block_cached__decode'

def setup_inputs():

    _w = (lambda a: (lambda t: t.to(torch.bfloat16) if t.is_floating_point() else t)(torch.as_tensor(a)))
    def _A_setup():
        B, Sq, D = 2, 1, 512
        Hq, Hkv, Sk, Dh = 32, 8, 8192, 128
        assert Hq % Hkv == 0, (Hq, Hkv)
        return {
            "x": _w((lambda *s: torch.randn(*s, dtype=torch.bfloat16) * 0.8)(B, Sq, D)),
            "k_cache": _w((lambda *s: torch.randn(*s, dtype=torch.bfloat16) * 1.6)(B, Hkv, Sk, Dh)),
            "v_cache": _w((lambda *s: torch.randn(*s, dtype=torch.bfloat16) * 0.2)(B, Hkv, Sk, Dh)),
            "wq": _w((lambda *s: torch.randn(*s, dtype=torch.bfloat16) * 1.6)(D, Hq * Dh) * (D ** -0.5)),
            "wo": _w((lambda *s: torch.randn(*s, dtype=torch.bfloat16) * 0.2)(Hq * Dh, D) * ((Hq * Dh) ** -0.5)),
        }
    _A_in = _A_setup()

    def _B_setup():
        B, Sq, D = 2, 1, 512
        Hq, Hkv, Sk, Dh = 32, 8, 8192, 128
        assert Hq % Hkv == 0, (Hq, Hkv)
        return {
            "x": _w((lambda *s: torch.randn(*s, dtype=torch.bfloat16) * 0.8)(B, Sq, D)),
            "k_cache": _w((lambda *s: torch.randn(*s, dtype=torch.bfloat16) * 1.6)(B, Hkv, Sk, Dh)),
            "v_cache": _w((lambda *s: torch.randn(*s, dtype=torch.bfloat16) * 0.2)(B, Hkv, Sk, Dh)),
            "wq": _w((lambda *s: torch.randn(*s, dtype=torch.bfloat16) * 1.6)(D, Hq * Dh) * (D ** -0.5)),
            "wo": _w((lambda *s: torch.randn(*s, dtype=torch.bfloat16) * 0.2)(Hq * Dh, D) * ((Hq * Dh) ** -0.5)),
        }
    _B_in = _B_setup()

    return {
        "A_x": _A_in["x"],
        "A_k_cache": _A_in["k_cache"],
        "A_v_cache": _A_in["v_cache"],
        "A_wq": _A_in["wq"],
        "A_wo": _A_in["wo"],
        "B_x": _B_in["x"],
        "B_k_cache": _B_in["k_cache"],
        "B_v_cache": _B_in["v_cache"],
        "B_wq": _B_in["wq"],
        "B_wo": _B_in["wo"],
    }

def reference(A_x, A_k_cache, A_v_cache, A_wq, A_wo, B_x, B_k_cache, B_v_cache, B_wq, B_wo):
    def _A_ref(x, k_cache, v_cache, wq, wo):
        B, Sq, D = x.shape
        Hq, Dh = 32, 128
        Hkv = k_cache.shape[1]
        rep = Hq // Hkv
        q = (lambda x, *d: x.permute(*d))((x @ wq).reshape(B, Sq, Hq, Dh), 0, 2, 1, 3)
        k = (lambda x, n, axis: torch.repeat_interleave(x, n, dim=axis))(k_cache, rep, axis=1)
        v = (lambda x, n, axis: torch.repeat_interleave(x, n, dim=axis))(v_cache, rep, axis=1)
        scores = torch.einsum("bhqd,bhkd->bhqk", q, k) * (Dh ** -0.5)
        p = _softmax(scores, axis=-1)
        o = torch.einsum("bhqk,bhkd->bhqd", p, v)
        return (lambda x, *d: x.permute(*d))(o, 0, 2, 1, 3).reshape(B, Sq, Hq * Dh) @ wo

    def _B_ref(x, k_cache, v_cache, wq, wo):
        B, Sq, D = x.shape
        Hq, Dh = 32, 128
        Hkv, Sk = k_cache.shape[1], k_cache.shape[2]
        W = min(4096, max(256, Sk // 4))
        rep = Hq // Hkv
        q = (lambda x, *d: x.permute(*d))((x @ wq).reshape(B, Sq, Hq, Dh), 0, 2, 1, 3)
        k = (lambda x, n, axis: torch.repeat_interleave(x, n, dim=axis))(k_cache[:, :, Sk - W:, :], rep, axis=1)
        v = (lambda x, n, axis: torch.repeat_interleave(x, n, dim=axis))(v_cache[:, :, Sk - W:, :], rep, axis=1)
        scores = torch.einsum("bhqd,bhkd->bhqk", q, k) * (Dh ** -0.5)
        p = _softmax(scores, axis=-1)
        o = torch.einsum("bhqk,bhkd->bhqd", p, v)
        return (lambda x, *d: x.permute(*d))(o, 0, 2, 1, 3).reshape(B, Sq, Hq * Dh) @ wo

    a = _A_ref(A_x, A_k_cache, A_v_cache, A_wq, A_wo)
    b = _B_ref(B_x, B_k_cache, B_v_cache, B_wq, B_wo)
    return torch.concatenate([a, b], axis=-1)
```

```asm
; @launch grid=(256,1,1) block=(768,1,1) lds=99840
.amdgcn_target "amdgcn-amd-amdhsa--gfx950"
.text
.globl concat_heads__gqa_block_cached__sliding_block_cached__decode_kernel
.p2align 8
.type concat_heads__gqa_block_cached__sliding_block_cached__decode_kernel,@function
concat_heads__gqa_block_cached__sliding_block_cached__decode_kernel:
    s_cmp_ge_u32 s2, 256
    s_cbranch_scc1 L_end
    s_load_dwordx16 s[16:31], s[0:1], 0
    s_load_dwordx8 s[32:39], s[0:1], 64
    s_load_dwordx2 s[40:41], s[0:1], 96
    v_lshrrev_b32 v1, 6, v0
    v_and_b32 v0, 63, v0
    v_readfirstlane_b32 s3, v1
    s_and_b32 s4, s2, 7
    s_lshr_b32 s5, s2, 3
    s_lshr_b32 s6, s5, 4
    s_and_b32 s7, s5, 15
    v_mov_b32 v4, 70144
    v_mov_b32 v5, 1
    s_mov_b32 s94, 0
    s_cmp_lt_u32 s3, 2
    s_cbranch_scc0 L_kv
    v_lshrrev_b32 v1, 3, v0
    v_lshlrev_b32 v1, 13, v1
    v_bfe_u32 v3, v0, 1, 2
    v_bfe_u32 v7, v0, 4, 1
    v_xor_b32 v3, v3, v7
    v_lshl_add_u32 v1, v3, 5, v1
    v_and_b32 v3, 1, v0
    v_lshl_add_u32 v1, v3, 4, v1
    v_xor_b32 v8, 64, v1
    v_lshlrev_b32 v2, 4, v0
    s_mov_b32 s43, s5
    s_cmp_eq_u32 s5, 6
    s_cselect_b32 s43, 16, s43
    s_cmp_eq_u32 s5, 16
    s_cselect_b32 s43, 6, s43
    s_cmp_eq_u32 s5, 7
    s_cselect_b32 s43, 24, s43
    s_cmp_eq_u32 s5, 24
    s_cselect_b32 s43, 7, s43
    s_cmp_eq_u32 s5, 22
    s_cselect_b32 s43, 18, s43
    s_cmp_eq_u32 s5, 18
    s_cselect_b32 s43, 22, s43
    s_cmp_eq_u32 s5, 23
    s_cselect_b32 s43, 26, s43
    s_cmp_eq_u32 s5, 26
    s_cselect_b32 s43, 23, s43
    s_lshr_b32 s95, s43, 4
    s_and_b32 s43, s43, 15
    s_lshl_b32 s52, s4, 10
    s_lshr_b32 s53, s43, 1
    s_lshl_b32 s53, s53, 7
    s_add_u32 s52, s52, s53
    s_and_b32 s42, s43, 1
    s_lshl_b32 s53, s42, 1
    s_add_u32 s53, s53, s3
    s_lshl_b32 s53, s53, 20
    s_add_u32 s53, s53, s52
    s_lshl_b32 s54, s3, 14
    s_waitcnt lgkmcnt(0)
    s_cmp_eq_u32 s95, 1
    s_cselect_b32 s44, s32, s22
    s_cselect_b32 s45, s33, s23
    s_mov_b32 s46, 0x400000
    s_mov_b32 s47, 0x20000
    s_cselect_b32 s48, s26, s16
    s_cselect_b32 s49, s27, s17
    s_mov_b32 s50, 0x800
    s_mov_b32 s51, 0x20000
    s_cmp_eq_u32 s6, 1
    s_cselect_b32 s64, s34, s24
    s_cselect_b32 s65, s35, s25
    s_mov_b32 s66, 0x400000
    s_mov_b32 s67, 0x20000
    s_mov_b32 s12, s40
    s_mov_b32 s13, s41
    s_mov_b32 s14, 0x10000000
    s_mov_b32 s15, 0x20000
    s_mov_b32 m0, s54
    s_add_u32 s54, s54, 1024
    buffer_load_dwordx4 v1, s[44:47], s53 offen nt lds
    s_add_u32 s53, s53, 0x10000
    s_mov_b32 m0, s54
    s_add_u32 s54, s54, 1024
    buffer_load_dwordx4 v8, s[44:47], s53 offen nt lds
    s_add_u32 s53, s53, 0x10000
    s_mov_b32 m0, s54
    s_add_u32 s54, s54, 1024
    buffer_load_dwordx4 v1, s[44:47], s53 offen nt lds
    s_add_u32 s53, s53, 0x10000
    s_mov_b32 m0, s54
    s_add_u32 s54, s54, 1024
    buffer_load_dwordx4 v8, s[44:47], s53 offen nt lds
    s_add_u32 s53, s53, 0x10000
    s_mov_b32 m0, s54
    s_add_u32 s54, s54, 1024
    buffer_load_dwordx4 v1, s[44:47], s53 offen nt lds
    s_add_u32 s53, s53, 0x10000
    s_mov_b32 m0, s54
    s_add_u32 s54, s54, 1024
    buffer_load_dwordx4 v8, s[44:47], s53 offen nt lds
    s_add_u32 s53, s53, 0x10000
    s_mov_b32 m0, s54
    s_add_u32 s54, s54, 1024
    buffer_load_dwordx4 v1, s[44:47], s53 offen nt lds
    s_add_u32 s53, s53, 0x10000
    s_mov_b32 m0, s54
    s_add_u32 s54, s54, 1024
    buffer_load_dwordx4 v8, s[44:47], s53 offen nt lds
    s_add_u32 s53, s53, 0x10000
    s_mov_b32 m0, s54
    s_add_u32 s54, s54, 1024
    buffer_load_dwordx4 v1, s[44:47], s53 offen nt lds
    s_add_u32 s53, s53, 0x10000
    s_mov_b32 m0, s54
    s_add_u32 s54, s54, 1024
    buffer_load_dwordx4 v8, s[44:47], s53 offen nt lds
    s_add_u32 s53, s53, 0x10000
    s_mov_b32 m0, s54
    s_add_u32 s54, s54, 1024
    buffer_load_dwordx4 v1, s[44:47], s53 offen nt lds
    s_add_u32 s53, s53, 0x10000
    s_mov_b32 m0, s54
    s_add_u32 s54, s54, 1024
    buffer_load_dwordx4 v8, s[44:47], s53 offen nt lds
    s_add_u32 s53, s53, 0x10000
    s_mov_b32 m0, s54
    s_add_u32 s54, s54, 1024
    buffer_load_dwordx4 v1, s[44:47], s53 offen nt lds
    s_add_u32 s53, s53, 0x10000
    s_mov_b32 m0, s54
    s_add_u32 s54, s54, 1024
    buffer_load_dwordx4 v8, s[44:47], s53 offen nt lds
    s_add_u32 s53, s53, 0x10000
    s_mov_b32 m0, s54
    s_add_u32 s54, s54, 1024
    buffer_load_dwordx4 v1, s[44:47], s53 offen nt lds
    s_add_u32 s53, s53, 0x10000
    s_mov_b32 m0, s54
    s_add_u32 s54, s54, 1024
    buffer_load_dwordx4 v8, s[44:47], s53 offen nt lds
    s_lshl_b32 s55, s3, 10
    s_add_u32 s54, s55, 65536
    s_mov_b32 m0, s54
    s_nop 0
    buffer_load_dwordx4 v2, s[48:51], s55 offen lds
    v_mov_b32 v3, 0
    v_lshl_add_u32 v7, v0, 2, v4
    s_mov_b64 exec, 0xffff
    ds_write_b32 v7, v3
    s_mov_b64 exec, -1
    s_waitcnt lgkmcnt(0)
    s_barrier
    s_branch L_helper2
L_kv:
    s_sub_u32 s42, s3, 2
    s_mul_i32 s9, s7, 10
    s_add_u32 s9, s9, s42
    v_and_b32 v1, 7, v0
    v_lshlrev_b32 v1, 8, v1
    v_lshrrev_b32 v3, 4, v0
    v_lshl_add_u32 v1, v3, 4, v1
    v_and_b32 v3, 8, v0
    v_lshl_add_u32 v1, v3, 3, v1
    v_lshlrev_b32 v2, 4, v0
    s_lshl_b32 s52, s6, 3
    s_add_u32 s52, s52, s4
    s_lshl_b32 s52, s52, 21
    s_waitcnt lgkmcnt(0)
    s_mov_b32 s12, s40
    s_mov_b32 s13, s41
    s_mov_b32 s14, 0x10000000
    s_mov_b32 s15, 0x20000
    s_cmp_ge_u32 s9, 128
    s_cselect_b32 s44, s28, s18
    s_cselect_b32 s45, s29, s19
    s_mov_b32 s46, 0x2000000
    s_mov_b32 s47, 0x20000
    s_cselect_b32 s48, s30, s20
    s_cselect_b32 s49, s31, s21
    s_mov_b32 s50, 0x2000000
    s_mov_b32 s51, 0x20000
    s_cselect_b32 s43, 1, 0
    s_cselect_b32 s53, 32, 0
    s_sub_u32 s9, s9, s53
    s_lshl_b32 s9, s9, 14
    s_add_u32 s52, s52, s9
    s_add_u32 s53, s52, 0x1000
    s_add_u32 s54, s52, 0x2000
    s_add_u32 s55, s52, 0x3000
    s_barrier
    s_lshl_b32 s9, s43, 2
    v_add_u32 v3, s9, v4
    buffer_load_dwordx4 v[8:11], v1, s[44:47], s52 offen offset:0 nt
    buffer_load_dwordx4 v[12:15], v1, s[44:47], s52 offen offset:128 nt
    buffer_load_dwordx4 v[16:19], v1, s[44:47], s52 offen offset:2048 nt
    buffer_load_dwordx4 v[20:23], v1, s[44:47], s52 offen offset:2176 nt
    buffer_load_dwordx4 v[24:27], v1, s[44:47], s53 offen offset:0 nt
    buffer_load_dwordx4 v[28:31], v1, s[44:47], s53 offen offset:128 nt
    buffer_load_dwordx4 v[32:35], v1, s[44:47], s53 offen offset:2048 nt
    buffer_load_dwordx4 v[36:39], v1, s[44:47], s53 offen offset:2176 nt
    buffer_load_dwordx4 v[40:43], v1, s[44:47], s54 offen offset:0 nt
    buffer_load_dwordx4 v[44:47], v1, s[44:47], s54 offen offset:128 nt
    buffer_load_dwordx4 v[48:51], v1, s[44:47], s54 offen offset:2048 nt
    buffer_load_dwordx4 v[52:55], v1, s[44:47], s54 offen offset:2176 nt
    buffer_load_dwordx4 v[56:59], v1, s[44:47], s55 offen offset:0 nt
    buffer_load_dwordx4 v[60:63], v1, s[44:47], s55 offen offset:128 nt
    buffer_load_dwordx4 v[64:67], v1, s[44:47], s55 offen offset:2048 nt
    buffer_load_dwordx4 v[68:71], v1, s[44:47], s55 offen offset:2176 nt
    s_mov_b32 s67, 0
    s_cmp_lt_u32 s42, 4
    s_cbranch_scc1 L_1
    buffer_load_dwordx4 v[72:75], v2, s[48:51], s52 offen offset:0 nt
    buffer_load_dwordx4 v[76:79], v2, s[48:51], s52 offen offset:1024 nt
    buffer_load_dwordx4 v[80:83], v2, s[48:51], s52 offen offset:2048 nt
    buffer_load_dwordx4 v[84:87], v2, s[48:51], s52 offen offset:3072 nt
    buffer_load_dwordx4 v[88:91], v2, s[48:51], s53 offen offset:0 nt
    buffer_load_dwordx4 v[92:95], v2, s[48:51], s53 offen offset:1024 nt
    buffer_load_dwordx4 v[96:99], v2, s[48:51], s53 offen offset:2048 nt
    buffer_load_dwordx4 v[100:103], v2, s[48:51], s53 offen offset:3072 nt
    buffer_load_dwordx4 v[104:107], v2, s[48:51], s54 offen offset:0 nt
    buffer_load_dwordx4 v[108:111], v2, s[48:51], s54 offen offset:1024 nt
    buffer_load_dwordx4 v[112:115], v2, s[48:51], s54 offen offset:2048 nt
    buffer_load_dwordx4 v[116:119], v2, s[48:51], s54 offen offset:3072 nt
    buffer_load_dwordx4 v[120:123], v2, s[48:51], s55 offen offset:0 nt
    buffer_load_dwordx4 v[124:127], v2, s[48:51], s55 offen offset:1024 nt
    buffer_load_dwordx4 v[128:131], v2, s[48:51], s55 offen offset:2048 nt
    buffer_load_dwordx4 v[132:135], v2, s[48:51], s55 offen offset:3072 nt
    s_mov_b64 exec, 1
    ds_add_u32 v4, v5 offset:12
    s_mov_b64 exec, -1
    s_mov_b32 s67, 1
    s_branch L_qwait
L_1:
    s_mov_b32 s10, 1048576
L_lw:
    ds_read_b32 v6, v3 offset:4
    ds_read_b32 v7, v4 offset:12
    s_waitcnt lgkmcnt(0)
    v_readfirstlane_b32 s9, v6
    v_readfirstlane_b32 s56, v7
    s_cmp_ge_u32 s9, 1
    s_cbranch_scc1 L_2
    s_cmp_ge_u32 s56, 6
    s_cbranch_scc1 L_vlate
    s_sleep 2
    s_sub_u32 s10, s10, 1
    s_cmp_lg_u32 s10, 0
    s_cbranch_scc1 L_lw
L_qwait:
    s_mov_b32 s10, 1048576
W_3:
    ds_read_b32 v6, v3 offset:4
    s_waitcnt lgkmcnt(0)
    v_readfirstlane_b32 s9, v6
    s_cmp_ge_u32 s9, 1
    s_cbranch_scc1 W_4
    s_sleep 2
    s_sub_u32 s10, s10, 1
    s_cmp_lg_u32 s10, 0
    s_cbranch_scc1 W_3
W_4:
L_2:
    v_and_b32 v3, 3, v0
    v_lshlrev_b32 v3, 8, v3
    v_and_b32 v7, 4, v0
    v_lshl_add_u32 v3, v7, 4, v3
    v_lshrrev_b32 v7, 4, v0
    v_lshl_add_u32 v3, v7, 4, v3
    s_lshl_b32 s9, s43, 10
    s_add_u32 s9, s9, 67584
    v_add_u32 v3, s9, v3
    ds_read_b128 v[136:139], v3
    ds_read_b128 v[144:147], v3 offset:128
    ds_read_b64 v[6:7], v4 offset:32
    s_mov_b32 s56, 0xff00ff
    s_mov_b32 s57, 0xff00ff
    s_waitcnt lgkmcnt(0)
    v_readfirstlane_b32 s68, v6
    v_readfirstlane_b32 s69, v7
    s_cmp_eq_u32 s6, 1
    s_cselect_b32 s8, s69, s68
    v_cndmask_b32 v140, v136, 0, s[56:57]
    v_cndmask_b32 v141, v137, 0, s[56:57]
    v_cndmask_b32 v142, v138, 0, s[56:57]
    v_cndmask_b32 v143, v139, 0, s[56:57]
    v_cndmask_b32 v136, 0, v136, s[56:57]
    v_cndmask_b32 v137, 0, v137, s[56:57]
    v_cndmask_b32 v138, 0, v138, s[56:57]
    v_cndmask_b32 v139, 0, v139, s[56:57]
    v_cndmask_b32 v148, v144, 0, s[56:57]
    v_cndmask_b32 v149, v145, 0, s[56:57]
    v_cndmask_b32 v150, v146, 0, s[56:57]
    v_cndmask_b32 v151, v147, 0, s[56:57]
    v_cndmask_b32 v144, 0, v144, s[56:57]
    v_cndmask_b32 v145, 0, v145, s[56:57]
    v_cndmask_b32 v146, 0, v146, s[56:57]
    v_cndmask_b32 v147, 0, v147, s[56:57]
    s_cmp_eq_u32 s67, 0
    s_cbranch_scc1 L_5
    s_waitcnt vmcnt(16)
    s_branch L_6
L_5:
    s_waitcnt vmcnt(0)
L_6:
    v_mfma_f32_16x16x32_bf16 v[152:155], v[136:139], v[8:11], 0
    v_mfma_f32_16x16x32_bf16 v[156:159], v[136:139], v[24:27], 0
    v_mfma_f32_16x16x32_bf16 v[160:163], v[136:139], v[40:43], 0
    v_mfma_f32_16x16x32_bf16 v[164:167], v[136:139], v[56:59], 0
    v_mfma_f32_16x16x32_bf16 v[152:155], v[144:147], v[12:15], v[152:155]
    v_mfma_f32_16x16x32_bf16 v[156:159], v[144:147], v[28:31], v[156:159]
    v_mfma_f32_16x16x32_bf16 v[160:163], v[144:147], v[44:47], v[160:163]
    v_mfma_f32_16x16x32_bf16 v[164:167], v[144:147], v[60:63], v[164:167]
    v_mfma_f32_16x16x32_bf16 v[152:155], v[140:143], v[16:19], v[152:155]
    v_mfma_f32_16x16x32_bf16 v[156:159], v[140:143], v[32:35], v[156:159]
    v_mfma_f32_16x16x32_bf16 v[160:163], v[140:143], v[48:51], v[160:163]
    v_mfma_f32_16x16x32_bf16 v[164:167], v[140:143], v[64:67], v[164:167]
    v_mfma_f32_16x16x32_bf16 v[152:155], v[148:151], v[20:23], v[152:155]
    v_mfma_f32_16x16x32_bf16 v[156:159], v[148:151], v[36:39], v[156:159]
    v_mfma_f32_16x16x32_bf16 v[160:163], v[148:151], v[52:55], v[160:163]
    v_mfma_f32_16x16x32_bf16 v[164:167], v[148:151], v[68:71], v[164:167]
    s_mov_b32 s58, 0xaaaaaaaa
    s_mov_b32 s59, 0xaaaaaaaa
    v_mov_b32 v20, 0x0c0c0100
    v_mov_b32 v21, 0x01000c0c
    v_mov_b32 v22, 0x0c0c0302
    v_mov_b32 v23, 0x03020c0c
    v_mov_b32 v24, 0x0c0c0c0c
    v_cndmask_b32 v20, v20, v21, s[58:59]
    v_cndmask_b32 v22, v22, v23, s[58:59]
    s_mov_b32 s60, 0x3030303
    s_mov_b32 s61, 0x3030303
    v_cndmask_b32 v40, v24, v20, s[60:61]
    v_cndmask_b32 v44, v24, v22, s[60:61]
    s_mov_b32 s60, 0xc0c0c0c
    s_mov_b32 s61, 0xc0c0c0c
    v_cndmask_b32 v41, v24, v20, s[60:61]
    v_cndmask_b32 v45, v24, v22, s[60:61]
    s_mov_b32 s60, 0x30303030
    s_mov_b32 s61, 0x30303030
    v_cndmask_b32 v42, v24, v20, s[60:61]
    v_cndmask_b32 v46, v24, v22, s[60:61]
    s_mov_b32 s60, 0xc0c0c0c0
    s_mov_b32 s61, 0xc0c0c0c0
    v_cndmask_b32 v43, v24, v20, s[60:61]
    v_cndmask_b32 v47, v24, v22, s[60:61]
    v_permlane16_swap_b32 v152, v156
    v_permlane16_swap_b32 v160, v164
    v_permlane16_swap_b32 v153, v157
    v_permlane16_swap_b32 v161, v165
    v_permlane16_swap_b32 v154, v158
    v_permlane16_swap_b32 v162, v166
    v_permlane16_swap_b32 v155, v159
    v_permlane16_swap_b32 v163, v167
    s_nop 1
    v_add_f32_dpp v8, v156, v152 row_ror:8 row_mask:0xf bank_mask:0x3
    v_add_f32_dpp v8, v160, v164 row_ror:8 row_mask:0xf bank_mask:0xc
    v_add_f32_dpp v9, v157, v153 row_ror:8 row_mask:0xf bank_mask:0x3
    v_add_f32_dpp v9, v161, v165 row_ror:8 row_mask:0xf bank_mask:0xc
    v_add_f32_dpp v10, v158, v154 row_ror:8 row_mask:0xf bank_mask:0x3
    v_add_f32_dpp v10, v162, v166 row_ror:8 row_mask:0xf bank_mask:0xc
    v_add_f32_dpp v11, v159, v155 row_ror:8 row_mask:0xf bank_mask:0x3
    v_add_f32_dpp v11, v163, v167 row_ror:8 row_mask:0xf bank_mask:0xc
    v_mul_f32 v8, 0x3e0293ee, v8
    v_mul_f32 v9, 0x3e0293ee, v9
    v_mul_f32 v10, 0x3e0293ee, v10
    v_mul_f32 v11, 0x3e0293ee, v11
    v_mov_b32 v12, v8
    v_mov_b32 v13, v9
    v_mov_b32 v14, v10
    v_mov_b32 v15, v11
    s_nop 0
    v_permlane32_swap_b32 v12, v13
    v_permlane32_swap_b32 v14, v15
    v_max_f32 v12, v12, v13
    v_max_f32 v14, v14, v15
    s_nop 1
    v_permlane16_swap_b32 v12, v14
    v_max_f32 v12, v12, v14
    s_nop 1
    v_max_f32_dpp v12, v12, v12 row_ror:8 row_mask:0xf bank_mask:0xf
    s_nop 1
    v_max_f32_dpp v12, v12, v12 row_ror:4 row_mask:0xf bank_mask:0xf
    s_nop 1
    v_max_f32_dpp v12, v12, v12 row_ror:2 row_mask:0xf bank_mask:0xf
    s_nop 1
    v_max_f32_dpp v12, v12, v12 row_ror:1 row_mask:0xf bank_mask:0xf
    v_lshrrev_b32 v18, 4, v0
    v_and_b32 v19, 1, v18
    v_lshrrev_b32 v18, 1, v18
    v_lshl_add_u32 v18, v19, 1, v18
    v_lshlrev_b32 v18, 6, v18
    s_lshl_b32 s9, s42, 2
    s_add_u32 s9, s9, 70400
    v_add_u32 v18, s9, v18
    ds_write_b32 v18, v12
    v_readlane_b32 s60, v12, 0
    v_readlane_b32 s61, v12, 32
    v_readlane_b32 s62, v12, 16
    v_readlane_b32 s63, v12, 48
    s_nop 1
    v_subrev_f32 v8, s60, v8
    v_subrev_f32 v9, s61, v9
    v_subrev_f32 v10, s62, v10
    v_subrev_f32 v11, s63, v11
    v_exp_f32 v8, v8
    v_exp_f32 v9, v9
    v_exp_f32 v10, v10
    v_exp_f32 v11, v11
    v_and_b32 v19, 3, v0
    v_mul_u32_u24 v19, 160, v19
    v_bfe_u32 v20, v0, 2, 1
    v_and_b32 v21, 8, v0
    v_add_u32 v20, v20, v21
    v_bfe_u32 v21, v0, 4, 1
    v_lshl_add_u32 v20, v21, 2, v20
    v_lshrrev_b32 v21, 5, v0
    v_lshl_add_u32 v20, v21, 1, v20
    v_lshl_add_u32 v19, v20, 2, v19
    s_mul_i32 s9, s42, 640
    s_add_u32 s9, s9, 71680
    v_add_u32 v19, s9, v19
    v_lshrrev_b32 v20, 3, v0
    v_mul_u32_u24 v20, 80, v20
    v_add_u32 v20, s9, v20
    v_cvt_pk_bf16_f32 v21, v8, v10
    v_cvt_pk_bf16_f32 v22, v9, v11
    ds_write2_b32 v19, v21, v22 offset0:0 offset1:20
    ds_read_b128 v[24:27], v20 offset:0
    ds_read_b128 v[28:31], v20 offset:16
    ds_read_b128 v[32:35], v20 offset:32
    ds_read_b128 v[36:39], v20 offset:48
    v_mov_b32 v136, v8
    v_mov_b32 v137, v9
    v_mov_b32 v138, v10
    v_mov_b32 v139, v11
    s_nop 0
    v_permlane32_swap_b32 v136, v137
    v_permlane32_swap_b32 v138, v139
    v_add_f32 v136, v136, v137
    v_add_f32 v138, v138, v139
    s_nop 1
    v_permlane16_swap_b32 v136, v138
    v_add_f32 v136, v136, v138
    s_nop 1
    v_add_f32_dpp v136, v136, v136 row_ror:8 row_mask:0xf bank_mask:0xf
    s_nop 1
    v_add_f32_dpp v136, v136, v136 row_ror:4 row_mask:0xf bank_mask:0xf
    s_nop 1
    v_add_f32_dpp v136, v136, v136 row_ror:2 row_mask:0xf bank_mask:0xf
    s_nop 1
    v_add_f32_dpp v136, v136, v136 row_ror:1 row_mask:0xf bank_mask:0xf
    ds_write_b32 v18, v136 offset:256
    s_mov_b64 exec, 1
    ds_add_u32 v4, v5 offset:16
    s_mov_b64 exec, -1
    v_and_b32 v18, 15, v0
    v_lshlrev_b32 v18, 5, v18
    v_and_b32 v19, 16, v0
    v_add_u32 v18, v18, v19
    v_lshrrev_b32 v19, 5, v0
    v_lshl_add_u32 v18, v19, 9, v18
    s_lshl_b32 s9, s42, 11
    s_add_u32 s9, s9, 78848
    v_add_u32 v18, s9, v18
    s_cmp_lt_u32 s42, 4
    s_cselect_b32 s9, 28, 20
    v_add_u32 v19, s9, v4
    s_cmp_lg_u32 s67, 0
    s_cbranch_scc1 L_7
    s_mov_b32 s10, 1048576
W_8:
    ds_read_b32 v6, v4 offset:12
    s_waitcnt lgkmcnt(0)
    v_readfirstlane_b32 s9, v6
    s_cmp_ge_u32 s9, 6
    s_cbranch_scc1 W_9
    s_sleep 2
    s_sub_u32 s10, s10, 1
    s_cmp_lg_u32 s10, 0
    s_cbranch_scc1 W_8
W_9:
    s_mov_b32 s67, 2
L_vlate:
    buffer_load_dwordx4 v[72:75], v2, s[48:51], s52 offen offset:0 nt
    buffer_load_dwordx4 v[76:79], v2, s[48:51], s52 offen offset:1024 nt
    buffer_load_dwordx4 v[80:83], v2, s[48:51], s52 offen offset:2048 nt
    buffer_load_dwordx4 v[84:87], v2, s[48:51], s52 offen offset:3072 nt
    buffer_load_dwordx4 v[88:91], v2, s[48:51], s53 offen offset:0 nt
    buffer_load_dwordx4 v[92:95], v2, s[48:51], s53 offen offset:1024 nt
    buffer_load_dwordx4 v[96:99], v2, s[48:51], s53 offen offset:2048 nt
    buffer_load_dwordx4 v[100:103], v2, s[48:51], s53 offen offset:3072 nt
    buffer_load_dwordx4 v[104:107], v2, s[48:51], s54 offen offset:0 nt
    buffer_load_dwordx4 v[108:111], v2, s[48:51], s54 offen offset:1024 nt
    buffer_load_dwordx4 v[112:115], v2, s[48:51], s54 offen offset:2048 nt
    buffer_load_dwordx4 v[116:119], v2, s[48:51], s54 offen offset:3072 nt
    buffer_load_dwordx4 v[120:123], v2, s[48:51], s55 offen offset:0 nt
    buffer_load_dwordx4 v[124:127], v2, s[48:51], s55 offen offset:1024 nt
    buffer_load_dwordx4 v[128:131], v2, s[48:51], s55 offen offset:2048 nt
    buffer_load_dwordx4 v[132:135], v2, s[48:51], s55 offen offset:3072 nt
    s_mov_b64 exec, 1
    ds_add_u32 v4, v5 offset:40
    s_mov_b64 exec, -1
    s_cmp_eq_u32 s67, 0
    s_mov_b32 s67, 1
    s_cbranch_scc1 L_qwait
L_7:
    s_waitcnt lgkmcnt(0)
    v_perm_b32 v48, v24, v24, v40
    v_perm_b32 v49, v24, v24, v41
    v_perm_b32 v50, v24, v24, v42
    v_perm_b32 v51, v24, v24, v43
    v_perm_b32 v52, v24, v24, v44
    v_perm_b32 v53, v24, v24, v45
    v_perm_b32 v54, v24, v24, v46
    v_perm_b32 v55, v24, v24, v47
    s_waitcnt vmcnt(15)
    v_mfma_f32_16x16x32_bf16 v[64:67], v[48:51], v[72:75], 0
    v_mfma_f32_16x16x32_bf16 v[68:71], v[52:55], v[72:75], 0
    v_perm_b32 v56, v25, v25, v40
    v_perm_b32 v57, v25, v25, v41
    v_perm_b32 v58, v25, v25, v42
    v_perm_b32 v59, v25, v25, v43
    v_perm_b32 v60, v25, v25, v44
    v_perm_b32 v61, v25, v25, v45
    v_perm_b32 v62, v25, v25, v46
    v_perm_b32 v63, v25, v25, v47
    s_waitcnt vmcnt(14)
    v_mfma_f32_16x16x32_bf16 v[64:67], v[56:59], v[76:79], v[64:67]
    v_mfma_f32_16x16x32_bf16 v[68:71], v[60:63], v[76:79], v[68:71]
    v_perm_b32 v48, v26, v26, v40
    v_perm_b32 v49, v26, v26, v41
    v_perm_b32 v50, v26, v26, v42
    v_perm_b32 v51, v26, v26, v43
    v_perm_b32 v52, v26, v26, v44
    v_perm_b32 v53, v26, v26, v45
    v_perm_b32 v54, v26, v26, v46
    v_perm_b32 v55, v26, v26, v47
    s_waitcnt vmcnt(13)
    v_mfma_f32_16x16x32_bf16 v[64:67], v[48:51], v[80:83], v[64:67]
    v_mfma_f32_16x16x32_bf16 v[68:71], v[52:55], v[80:83], v[68:71]
    v_perm_b32 v56, v27, v27, v40
    v_perm_b32 v57, v27, v27, v41
    v_perm_b32 v58, v27, v27, v42
    v_perm_b32 v59, v27, v27, v43
    v_perm_b32 v60, v27, v27, v44
    v_perm_b32 v61, v27, v27, v45
    v_perm_b32 v62, v27, v27, v46
    v_perm_b32 v63, v27, v27, v47
    s_waitcnt vmcnt(12)
    v_mfma_f32_16x16x32_bf16 v[64:67], v[56:59], v[84:87], v[64:67]
    v_mfma_f32_16x16x32_bf16 v[68:71], v[60:63], v[84:87], v[68:71]
    v_perm_b32 v48, v28, v28, v40
    v_perm_b32 v49, v28, v28, v41
    v_perm_b32 v50, v28, v28, v42
    v_perm_b32 v51, v28, v28, v43
    v_perm_b32 v52, v28, v28, v44
    v_perm_b32 v53, v28, v28, v45
    v_perm_b32 v54, v28, v28, v46
    v_perm_b32 v55, v28, v28, v47
    s_waitcnt vmcnt(11)
    v_mfma_f32_16x16x32_bf16 v[64:67], v[48:51], v[88:91], v[64:67]
    v_mfma_f32_16x16x32_bf16 v[68:71], v[52:55], v[88:91], v[68:71]
    v_perm_b32 v56, v29, v29, v40
    v_perm_b32 v57, v29, v29, v41
    v_perm_b32 v58, v29, v29, v42
    v_perm_b32 v59, v29, v29, v43
    v_perm_b32 v60, v29, v29, v44
    v_perm_b32 v61, v29, v29, v45
    v_perm_b32 v62, v29, v29, v46
    v_perm_b32 v63, v29, v29, v47
    s_waitcnt vmcnt(10)
    v_mfma_f32_16x16x32_bf16 v[64:67], v[56:59], v[92:95], v[64:67]
    v_mfma_f32_16x16x32_bf16 v[68:71], v[60:63], v[92:95], v[68:71]
    v_perm_b32 v48, v30, v30, v40
    v_perm_b32 v49, v30, v30, v41
    v_perm_b32 v50, v30, v30, v42
    v_perm_b32 v51, v30, v30, v43
    v_perm_b32 v52, v30, v30, v44
    v_perm_b32 v53, v30, v30, v45
    v_perm_b32 v54, v30, v30, v46
    v_perm_b32 v55, v30, v30, v47
    s_waitcnt vmcnt(9)
    v_mfma_f32_16x16x32_bf16 v[64:67], v[48:51], v[96:99], v[64:67]
    v_mfma_f32_16x16x32_bf16 v[68:71], v[52:55], v[96:99], v[68:71]
    v_perm_b32 v56, v31, v31, v40
    v_perm_b32 v57, v31, v31, v41
    v_perm_b32 v58, v31, v31, v42
    v_perm_b32 v59, v31, v31, v43
    v_perm_b32 v60, v31, v31, v44
    v_perm_b32 v61, v31, v31, v45
    v_perm_b32 v62, v31, v31, v46
    v_perm_b32 v63, v31, v31, v47
    s_waitcnt vmcnt(8)
    v_mfma_f32_16x16x32_bf16 v[64:67], v[56:59], v[100:103], v[64:67]
    v_mfma_f32_16x16x32_bf16 v[68:71], v[60:63], v[100:103], v[68:71]
    v_perm_b32 v48, v32, v32, v40
    v_perm_b32 v49, v32, v32, v41
    v_perm_b32 v50, v32, v32, v42
    v_perm_b32 v51, v32, v32, v43
    v_perm_b32 v52, v32, v32, v44
    v_perm_b32 v53, v32, v32, v45
    v_perm_b32 v54, v32, v32, v46
    v_perm_b32 v55, v32, v32, v47
    s_waitcnt vmcnt(7)
    v_mfma_f32_16x16x32_bf16 v[64:67], v[48:51], v[104:107], v[64:67]
    v_mfma_f32_16x16x32_bf16 v[68:71], v[52:55], v[104:107], v[68:71]
    v_perm_b32 v56, v33, v33, v40
    v_perm_b32 v57, v33, v33, v41
    v_perm_b32 v58, v33, v33, v42
    v_perm_b32 v59, v33, v33, v43
    v_perm_b32 v60, v33, v33, v44
    v_perm_b32 v61, v33, v33, v45
    v_perm_b32 v62, v33, v33, v46
    v_perm_b32 v63, v33, v33, v47
    s_waitcnt vmcnt(6)
    v_mfma_f32_16x16x32_bf16 v[64:67], v[56:59], v[108:111], v[64:67]
    v_mfma_f32_16x16x32_bf16 v[68:71], v[60:63], v[108:111], v[68:71]
    v_perm_b32 v48, v34, v34, v40
    v_perm_b32 v49, v34, v34, v41
    v_perm_b32 v50, v34, v34, v42
    v_perm_b32 v51, v34, v34, v43
    v_perm_b32 v52, v34, v34, v44
    v_perm_b32 v53, v34, v34, v45
    v_perm_b32 v54, v34, v34, v46
    v_perm_b32 v55, v34, v34, v47
    s_waitcnt vmcnt(5)
    v_mfma_f32_16x16x32_bf16 v[64:67], v[48:51], v[112:115], v[64:67]
    v_mfma_f32_16x16x32_bf16 v[68:71], v[52:55], v[112:115], v[68:71]
    v_perm_b32 v56, v35, v35, v40
    v_perm_b32 v57, v35, v35, v41
    v_perm_b32 v58, v35, v35, v42
    v_perm_b32 v59, v35, v35, v43
    v_perm_b32 v60, v35, v35, v44
    v_perm_b32 v61, v35, v35, v45
    v_perm_b32 v62, v35, v35, v46
    v_perm_b32 v63, v35, v35, v47
    s_waitcnt vmcnt(4)
    v_mfma_f32_16x16x32_bf16 v[64:67], v[56:59], v[116:119], v[64:67]
    v_mfma_f32_16x16x32_bf16 v[68:71], v[60:63], v[116:119], v[68:71]
    v_perm_b32 v48, v36, v36, v40
    v_perm_b32 v49, v36, v36, v41
    v_perm_b32 v50, v36, v36, v42
    v_perm_b32 v51, v36, v36, v43
    v_perm_b32 v52, v36, v36, v44
    v_perm_b32 v53, v36, v36, v45
    v_perm_b32 v54, v36, v36, v46
    v_perm_b32 v55, v36, v36, v47
    s_waitcnt vmcnt(3)
    v_mfma_f32_16x16x32_bf16 v[64:67], v[48:51], v[120:123], v[64:67]
    v_mfma_f32_16x16x32_bf16 v[68:71], v[52:55], v[120:123], v[68:71]
    v_perm_b32 v56, v37, v37, v40
    v_perm_b32 v57, v37, v37, v41
    v_perm_b32 v58, v37, v37, v42
    v_perm_b32 v59, v37, v37, v43
    v_perm_b32 v60, v37, v37, v44
    v_perm_b32 v61, v37, v37, v45
    v_perm_b32 v62, v37, v37, v46
    v_perm_b32 v63, v37, v37, v47
    s_waitcnt vmcnt(2)
    v_mfma_f32_16x16x32_bf16 v[64:67], v[56:59], v[124:127], v[64:67]
    v_mfma_f32_16x16x32_bf16 v[68:71], v[60:63], v[124:127], v[68:71]
    v_perm_b32 v48, v38, v38, v40
    v_perm_b32 v49, v38, v38, v41
    v_perm_b32 v50, v38, v38, v42
    v_perm_b32 v51, v38, v38, v43
    v_perm_b32 v52, v38, v38, v44
    v_perm_b32 v53, v38, v38, v45
    v_perm_b32 v54, v38, v38, v46
    v_perm_b32 v55, v38, v38, v47
    s_waitcnt vmcnt(1)
    v_mfma_f32_16x16x32_bf16 v[64:67], v[48:51], v[128:131], v[64:67]
    v_mfma_f32_16x16x32_bf16 v[68:71], v[52:55], v[128:131], v[68:71]
    v_perm_b32 v56, v39, v39, v40
    v_perm_b32 v57, v39, v39, v41
    v_perm_b32 v58, v39, v39, v42
    v_perm_b32 v59, v39, v39, v43
    v_perm_b32 v60, v39, v39, v44
    v_perm_b32 v61, v39, v39, v45
    v_perm_b32 v62, v39, v39, v46
    v_perm_b32 v63, v39, v39, v47
    s_waitcnt vmcnt(0)
    v_mfma_f32_16x16x32_bf16 v[64:67], v[56:59], v[132:135], v[64:67]
    v_mfma_f32_16x16x32_bf16 v[68:71], v[60:63], v[132:135], v[68:71]
    s_nop 6
    ds_write_b128 v18, v[64:67]
    ds_write_b128 v18, v[68:71] offset:1024
    s_mov_b64 exec, 1
    ds_add_u32 v19, v5 offset:0
    s_mov_b64 exec, -1
    s_cmp_lt_u32 s42, 2
    s_cbranch_scc1 L_kv_tail
    s_cmp_ge_u32 s42, 8
    s_cbranch_scc1 L_gather
    s_mov_b32 s43, s42
    s_cmp_lt_u32 s42, 4
    s_cbranch_scc1 L_kv_proj
    s_sub_u32 s63, s42, 4
    v_lshlrev_b32 v18, 3, v0
    s_lshl_b32 s9, s63, 9
    s_add_u32 s9, s9, 78848
    v_add_u32 v19, s9, v18
    s_lshl_b32 s9, s63, 6
    s_add_u32 s9, s9, 70400
    v_mov_b32 v20, s9
    s_lshl_b32 s56, s6, 3
    s_add_u32 s56, s56, s4
    s_lshl_b32 s56, s56, 2
    s_add_u32 s56, s56, s63
    s_lshl_b32 s56, s56, 14
    s_add_u32 s56, s56, 524288
    s_cmp_gt_u32 s7, 12
    s_cselect_b32 s60, s69, s68
    s_addc_u32 s57, s7, 0
    s_lshl_b32 s58, s57, 9
    s_add_u32 s58, s58, s56
    s_lshl_b32 s59, s57, 7
    s_add_u32 s59, s59, s56
    s_add_u32 s59, s59, 12288
    s_add_u32 s61, s58, 16777216
    s_add_u32 s62, s59, 16777216
    v_lshlrev_b32 v21, 4, v0
    s_mov_b32 s10, 1048576
W_10:
    ds_read_b32 v6, v4 offset:16
    s_waitcnt lgkmcnt(0)
    v_readfirstlane_b32 s9, v6
    s_cmp_ge_u32 s9, 10
    s_cbranch_scc1 W_11
    s_sleep 1
    s_sub_u32 s10, s10, 1
    s_cmp_lg_u32 s10, 0
    s_cbranch_scc1 W_10
W_11:
    ds_read_b128 v[72:75], v20
    ds_read_b128 v[76:79], v20 offset:16
    ds_read_b64 v[80:81], v20 offset:32
    ds_read_b128 v[84:87], v20 offset:256
    ds_read_b128 v[88:91], v20 offset:272
    ds_read_b64 v[92:93], v20 offset:288
    v_mov_b32 v49, s60
    v_mov_b32 v51, s60
    v_mov_b32 v45, s60
    v_mov_b32 v57, s69
    v_mov_b32 v59, s69
    v_mov_b32 v47, s69
    s_waitcnt lgkmcnt(0)
    v_max3_f32 v48, v72, v73, v74
    v_max3_f32 v52, v75, v76, v77
    v_max3_f32 v48, v48, v78, v79
    v_max_f32 v48, v48, v52
    v_max_f32 v56, v80, v81
    s_cmp_eq_u32 s7, 12
    s_cbranch_scc1 L_12
    v_max_f32 v48, v48, v56
    v_mov_b32 v56, v48
L_12:
    v_sub_f32 v72, v72, v48
    v_sub_f32 v73, v73, v48
    v_sub_f32 v74, v74, v48
    v_sub_f32 v75, v75, v48
    v_sub_f32 v76, v76, v48
    v_sub_f32 v77, v77, v48
    v_sub_f32 v78, v78, v48
    v_sub_f32 v79, v79, v48
    v_sub_f32 v80, v80, v56
    v_sub_f32 v81, v81, v56
    v_exp_f32 v72, v72
    v_exp_f32 v73, v73
    v_exp_f32 v74, v74
    v_exp_f32 v75, v75
    v_exp_f32 v76, v76
    v_exp_f32 v77, v77
    v_exp_f32 v78, v78
    v_exp_f32 v79, v79
    v_exp_f32 v80, v80
    v_exp_f32 v81, v81
    v_mul_f32 v50, v72, v84
    v_fmac_f32 v50, v73, v85
    v_fmac_f32 v50, v74, v86
    v_fmac_f32 v50, v75, v87
    v_fmac_f32 v50, v76, v88
    v_fmac_f32 v50, v77, v89
    v_fmac_f32 v50, v78, v90
    v_fmac_f32 v50, v79, v91
    v_mul_f32 v58, v80, v92
    v_fmac_f32 v58, v81, v93
    s_cbranch_scc1 L_13
    v_add_f32 v50, v50, v58
    s_mov_b64 exec, 0xff
    buffer_store_dwordx4 v[48:51], v21, s[12:15], s59 offen
    buffer_store_dwordx4 v[48:51], v21, s[12:15], s62 offen sc1
    s_branch L_14
L_13:
    s_mov_b64 exec, 0xff
    buffer_store_dwordx4 v[48:51], v21, s[12:15], s59 offen
    buffer_store_dwordx4 v[56:59], v21, s[12:15], s59 offen offset:128
    buffer_store_dwordx4 v[48:51], v21, s[12:15], s62 offen sc1
    buffer_store_dwordx4 v[56:59], v21, s[12:15], s62 offen offset:128 sc1
L_14:
    s_mov_b64 exec, -1
    s_mov_b32 s10, 1048576
W_15:
    ds_read_b32 v6, v4 offset:20
    s_waitcnt lgkmcnt(0)
    v_readfirstlane_b32 s9, v6
    s_cmp_ge_u32 s9, 6
    s_cbranch_scc1 W_16
    s_sleep 1
    s_sub_u32 s10, s10, 1
    s_cmp_lg_u32 s10, 0
    s_cbranch_scc1 W_15
W_16:
    ds_read_b64 v[32:33], v19 offset:8192
    ds_read_b64 v[34:35], v19 offset:10240
    ds_read_b64 v[36:37], v19 offset:12288
    ds_read_b64 v[38:39], v19 offset:14336
    ds_read_b64 v[40:41], v19 offset:16384
    ds_read_b64 v[42:43], v19 offset:18432
    s_waitcnt lgkmcnt(0)
    v_mul_f32 v60, v76, v32
    v_mul_f32 v62, v80, v40
    v_mul_f32 v61, v76, v33
    v_mul_f32 v63, v80, v41
    v_fmac_f32 v60, v77, v34
    v_fmac_f32 v61, v77, v35
    v_fmac_f32 v60, v78, v36
    v_fmac_f32 v61, v78, v37
    v_fmac_f32 v60, v79, v38
    v_fmac_f32 v61, v79, v39
    v_fmac_f32 v62, v81, v42
    v_fmac_f32 v63, v81, v43
    s_cmp_eq_u32 s7, 12
    s_cbranch_scc1 L_17
    v_add_f32 v60, v60, v62
    v_add_f32 v61, v61, v63
    s_branch L_18
L_17:
    v_cvt_pk_bf16_f32 v46, v62, v63
    buffer_store_dwordx2 v[46:47], v18, s[12:15], s58 offen offset:512
    buffer_store_dwordx2 v[46:47], v18, s[12:15], s61 offen offset:512 sc1
L_18:
    s_mov_b32 s10, 1048576
W_19:
    ds_read_b32 v6, v4 offset:28
    s_waitcnt lgkmcnt(0)
    v_readfirstlane_b32 s9, v6
    s_cmp_ge_u32 s9, 4
    s_cbranch_scc1 W_20
    s_sub_u32 s10, s10, 1
    s_cmp_lg_u32 s10, 0
    s_cbranch_scc1 W_19
W_20:
    ds_read_b64 v[24:25], v19 offset:0
    ds_read_b64 v[26:27], v19 offset:2048
    ds_read_b64 v[28:29], v19 offset:4096
    ds_read_b64 v[30:31], v19 offset:6144
    s_waitcnt lgkmcnt(3)
    v_fmac_f32 v60, v72, v24
    v_fmac_f32 v61, v72, v25
    s_waitcnt lgkmcnt(2)
    v_fmac_f32 v60, v73, v26
    v_fmac_f32 v61, v73, v27
    s_waitcnt lgkmcnt(1)
    v_fmac_f32 v60, v74, v28
    v_fmac_f32 v61, v74, v29
    s_waitcnt lgkmcnt(0)
    v_fmac_f32 v60, v75, v30
    v_fmac_f32 v61, v75, v31
    v_cvt_pk_bf16_f32 v44, v60, v61
    buffer_store_dwordx2 v[44:45], v18, s[12:15], s58 offen
    v_mov_b32 v100, v18
    v_mov_b32 v102, v44
    v_mov_b32 v103, v45
    s_mov_b32 s64, s61
    s_mov_b32 s66, 1
    s_branch L_kv_proj2
L_kv_proj:
    s_mov_b32 s66, 0
L_kv_proj2:
    v_lshrrev_b32 v18, 4, v0
    v_bfe_u32 v19, v0, 2, 2
    v_and_b32 v20, 3, v0
    v_lshl_add_u32 v21, v18, 3, v19
    v_lshlrev_b32 v21, 8, v21
    v_lshl_add_u32 v21, v20, 3, v21
    v_and_b32 v22, 1, v18
    v_lshl_add_u32 v22, v22, 2, v19
    v_xor_b32 v22, s43, v22
    v_lshl_add_u32 v21, v22, 5, v21
    v_add_u32 v21, 32768, v21
    v_and_b32 v22, 1, v0
    v_lshlrev_b32 v22, 8, v22
    v_lshl_add_u32 v22, v18, 4, v22
    v_add_u32 v22, 99328, v22
    s_and_b32 s56, s7, 3
    s_lshr_b32 s57, s7, 2
    s_lshl_b32 s58, s4, 2
    s_add_u32 s58, s58, s57
    s_lshl_b32 s59, s6, 7
    s_lshl_b32 s60, s56, 4
    s_add_u32 s59, s59, s60
    s_lshl_b32 s60, s43, 1
    s_add_u32 s59, s59, s60
    s_lshl_b32 s59, s59, 5
    s_add_u32 s59, s59, s58
    s_lshl_b32 s59, s59, 6
    s_add_u32 s59, s59, 1572864
    v_and_b32 v23, 7, v0
    v_lshlrev_b32 v23, 3, v23
    v_bfe_u32 v24, v0, 3, 1
    v_lshl_add_u32 v23, v24, 11, v23
    v_bfe_u32 v24, v0, 4, 1
    v_lshl_add_u32 v23, v24, 17, v23
    s_mov_b32 s60, 0xffff
    s_mov_b32 s61, 0x0
    v_mov_b32 v97, s8
    s_mov_b32 s10, 1048576
W_21:
    ds_read_b32 v6, v4 offset:44
    s_waitcnt lgkmcnt(0)
    v_readfirstlane_b32 s9, v6
    s_cmp_ge_u32 s9, 2
    s_cbranch_scc1 W_22
    s_sleep 1
    s_sub_u32 s10, s10, 1
    s_cmp_lg_u32 s10, 0
    s_cbranch_scc1 W_21
W_22:
    ds_read_b64_tr_b16 v[56:57], v21 offset:0
    ds_read_b64_tr_b16 v[58:59], v21 offset:1024
    ds_read_b64_tr_b16 v[60:61], v21 offset:8192
    ds_read_b64_tr_b16 v[62:63], v21 offset:9216
    ds_read_b64_tr_b16 v[64:65], v21 offset:16384
    ds_read_b64_tr_b16 v[66:67], v21 offset:17408
    ds_read_b64_tr_b16 v[68:69], v21 offset:24576
    ds_read_b64_tr_b16 v[70:71], v21 offset:25600
    s_mov_b32 s10, 40
W_24:
    ds_read_b32 v6, v4 offset:24
    s_waitcnt lgkmcnt(0)
    v_readfirstlane_b32 s9, v6
    s_cmp_ge_u32 s9, 2
    s_cbranch_scc1 W_25
    s_sub_u32 s10, s10, 1
    s_cmp_lg_u32 s10, 0
    s_cbranch_scc1 W_24
W_25:
    s_cmp_lg_u32 s10, 0
    s_cbranch_scc1 L_23
    s_cmp_eq_u32 s66, 0
    s_cbranch_scc1 L_26
    s_mov_b32 s66, 0
    s_mov_b64 exec, -1
    buffer_store_dwordx2 v[102:103], v100, s[12:15], s64 offen sc1
L_26:
    s_mov_b32 s10, 1048576
W_27:
    ds_read_b32 v6, v4 offset:24
    s_waitcnt lgkmcnt(0)
    v_readfirstlane_b32 s9, v6
    s_cmp_ge_u32 s9, 2
    s_cbranch_scc1 W_28
    s_sub_u32 s10, s10, 1
    s_cmp_lg_u32 s10, 0
    s_cbranch_scc1 W_27
W_28:
L_23:
    ds_read_b128 v[24:27], v22 offset:0
    ds_read_b128 v[28:31], v22 offset:64
    ds_read_b128 v[32:35], v22 offset:128
    ds_read_b128 v[36:39], v22 offset:192
    s_waitcnt lgkmcnt(3)
    v_mfma_f32_16x16x32_bf16 v[72:75], v[24:27], v[56:59], 0
    s_waitcnt lgkmcnt(2)
    v_mfma_f32_16x16x32_bf16 v[72:75], v[28:31], v[60:63], v[72:75]
    s_waitcnt lgkmcnt(1)
    v_mfma_f32_16x16x32_bf16 v[72:75], v[32:35], v[64:67], v[72:75]
    s_waitcnt lgkmcnt(0)
    v_mfma_f32_16x16x32_bf16 v[72:75], v[36:39], v[68:71], v[72:75]
    s_mov_b32 exec_hi, 0
    s_nop 6
    v_cndmask_b32 v96, v73, v72, s[60:61]
    buffer_store_dwordx2 v[96:97], v23, s[12:15], s59 offen sc1
    s_cmp_eq_u32 s66, 0
    s_cbranch_scc1 L_29
    s_mov_b32 s66, 0
    s_mov_b64 exec, -1
    buffer_store_dwordx2 v[102:103], v100, s[12:15], s64 offen sc1
L_29:
    s_endpgm
L_kv_tail:
    s_cmp_eq_u32 s42, 0
    s_cbranch_scc1 L_final
    s_endpgm
L_final:
    s_mov_b32 s44, s36
    s_mov_b32 s45, s37
    s_mov_b32 s46, 0x1000
    s_mov_b32 s47, 0x20000
    s_lshl_b32 s56, s2, 11
    s_add_u32 s56, s56, 1572864
    s_lshr_b32 s57, s2, 7
    s_lshl_b32 s57, s57, 10
    s_bfe_u32 s58, s2, 0x10006
    s_lshl_b32 s58, s58, 11
    s_add_u32 s57, s57, s58
    s_and_b32 s58, s2, 63
    s_lshl_b32 s58, s58, 4
    s_add_u32 s57, s57, s58
    v_lshlrev_b32 v18, 4, v0
    v_lshlrev_b32 v19, 2, v0
    s_mov_b32 s10, 1048576
W_30:
    ds_read_b32 v6, v4 offset:24
    s_waitcnt lgkmcnt(0)
    v_readfirstlane_b32 s9, v6
    s_cmp_ge_u32 s9, 2
    s_cbranch_scc1 W_31
    s_sleep 1
    s_sub_u32 s10, s10, 1
    s_cmp_lg_u32 s10, 0
    s_cbranch_scc1 W_30
W_31:
    s_mov_b32 s10, 0x40000
P_32:
    buffer_load_dwordx4 v[24:27], v18, s[12:15], s56 offen sc1
    buffer_load_dwordx4 v[28:31], v18, s[12:15], s56 offen offset:1024 sc1
    s_waitcnt vmcnt(0)
    v_min_u32 v32, v25, v27
    v_max_u32 v33, v25, v27
    v_min3_u32 v32, v32, v29, v31
    v_max3_u32 v33, v33, v29, v31
    v_cmp_eq_u32 vcc, s8, v32
    v_cmp_eq_u32 s[58:59], s8, v33
    s_and_b64 vcc, vcc, s[58:59]
    s_cmp_eq_u64 vcc, -1
    s_cbranch_scc1 P_33
    s_sub_u32 s10, s10, 1
    s_cmp_lg_u32 s10, 0
    s_cbranch_scc1 P_32
P_33:
L_fin_dry:
    v_add_f32 v24, v24, v28
    v_add_f32 v26, v26, v30
    s_nop 1
    v_permlane32_swap_b32 v24, v26
    v_add_f32 v24, v24, v26
    v_mov_b32 v25, v24
    s_nop 1
    v_permlane16_swap_b32 v24, v25
    v_add_f32 v24, v24, v25
    s_nop 1
    v_add_f32_dpp v24, v24, v24 row_ror:8 row_mask:0xf bank_mask:0xf
    s_nop 1
    v_add_f32_dpp v24, v24, v24 row_ror:4 row_mask:0xf bank_mask:0xf
    v_mov_b32 v25, v24
    s_nop 1
    v_permlane32_swap_b32 v24, v25
    v_cvt_pk_bf16_f32 v24, v24, v25
    s_mov_b64 exec, 0xf
    buffer_store_dword v24, v19, s[44:47], s57 offen
    s_and_b32 s58, s2, 127
    s_cmp_lg_u32 s58, 0
    s_cbranch_scc1 L_34
    s_mov_b64 exec, 1
    v_mov_b32 v25, s8
    s_lshl_b32 s58, s6, 2
    buffer_store_dword v25, v19, s[12:15], s58 offen offset:0 sc1
L_34:
    s_endpgm
L_helper2:
    s_cmp_lg_u32 s3, 0
    s_cbranch_scc1 L_35
    s_load_dwordx2 s[68:69], s[40:41], 0
    s_waitcnt lgkmcnt(0)
    s_add_u32 s68, s68, 1
    s_add_u32 s69, s69, 1
    v_mov_b32 v6, s68
    v_mov_b32 v7, s69
    ds_write_b64 v4, v[6:7] offset:32
L_35:
    v_lshrrev_b32 v18, 4, v0
    v_bfe_u32 v19, v0, 2, 2
    v_and_b32 v20, 3, v0
    v_lshl_add_u32 v21, v18, 3, v19
    v_lshlrev_b32 v21, 7, v21
    v_lshl_add_u32 v21, v20, 3, v21
    v_lshrrev_b32 v19, 1, v19
    v_and_b32 v20, 1, v18
    v_lshl_add_u32 v19, v20, 1, v19
    s_lshl_b32 s9, s3, 1
    v_xor_b32 v19, s9, v19
    v_lshl_add_u32 v21, v19, 5, v21
    v_xor_b32 v23, 32, v21
    v_and_b32 v22, 1, v0
    v_lshlrev_b32 v22, 10, v22
    v_lshl_add_u32 v22, v18, 4, v22
    s_lshl_b32 s9, s42, 9
    s_add_u32 s9, s9, 65536
    v_add_u32 v22, s9, v22
    s_waitcnt vmcnt(0)
    s_mov_b64 exec, 1
    ds_add_u32 v4, v5 offset:0
    s_mov_b64 exec, -1
    s_mov_b32 s10, 1048576
W_36:
    ds_read_b32 v6, v4 offset:0
    s_waitcnt lgkmcnt(0)
    v_readfirstlane_b32 s9, v6
    s_cmp_ge_u32 s9, 2
    s_cbranch_scc1 W_37
    s_sub_u32 s10, s10, 1
    s_cmp_lg_u32 s10, 0
    s_cbranch_scc1 W_36
W_37:
    ds_read_b64 v[6:7], v4 offset:32
    ds_read_b128 v[24:27], v22 offset:0
    ds_read_b64_tr_b16 v[40:41], v21 offset:0
    ds_read_b64_tr_b16 v[42:43], v21 offset:512
    ds_read_b64_tr_b16 v[44:45], v23 offset:0
    ds_read_b64_tr_b16 v[46:47], v23 offset:512
    ds_read_b128 v[28:31], v22 offset:64
    ds_read_b64_tr_b16 v[48:49], v21 offset:4096
    ds_read_b64_tr_b16 v[50:51], v21 offset:4608
    ds_read_b64_tr_b16 v[52:53], v23 offset:4096
    ds_read_b64_tr_b16 v[54:55], v23 offset:4608
    s_waitcnt lgkmcnt(0)
    v_mfma_f32_16x16x32_bf16 v[88:91], v[24:27], v[40:43], 0
    v_mfma_f32_16x16x32_bf16 v[92:95], v[24:27], v[44:47], 0
    v_mfma_f32_16x16x32_bf16 v[88:91], v[28:31], v[48:51], v[88:91]
    v_mfma_f32_16x16x32_bf16 v[92:95], v[28:31], v[52:55], v[92:95]
    ds_read_b128 v[32:35], v22 offset:128
    ds_read_b64_tr_b16 v[56:57], v21 offset:8192
    ds_read_b64_tr_b16 v[58:59], v21 offset:8704
    ds_read_b64_tr_b16 v[60:61], v23 offset:8192
    ds_read_b64_tr_b16 v[62:63], v23 offset:8704
    ds_read_b128 v[36:39], v22 offset:192
    ds_read_b64_tr_b16 v[64:65], v21 offset:12288
    ds_read_b64_tr_b16 v[66:67], v21 offset:12800
    ds_read_b64_tr_b16 v[68:69], v23 offset:12288
    ds_read_b64_tr_b16 v[70:71], v23 offset:12800
    s_waitcnt lgkmcnt(0)
    v_mfma_f32_16x16x32_bf16 v[88:91], v[32:35], v[56:59], v[88:91]
    v_mfma_f32_16x16x32_bf16 v[92:95], v[32:35], v[60:63], v[92:95]
    v_mfma_f32_16x16x32_bf16 v[88:91], v[36:39], v[64:67], v[88:91]
    v_mfma_f32_16x16x32_bf16 v[92:95], v[36:39], v[68:71], v[92:95]
    ds_read_b128 v[24:27], v22 offset:256
    ds_read_b64_tr_b16 v[40:41], v21 offset:16384
    ds_read_b64_tr_b16 v[42:43], v21 offset:16896
    ds_read_b64_tr_b16 v[44:45], v23 offset:16384
    ds_read_b64_tr_b16 v[46:47], v23 offset:16896
    ds_read_b128 v[28:31], v22 offset:320
    ds_read_b64_tr_b16 v[48:49], v21 offset:20480
    ds_read_b64_tr_b16 v[50:51], v21 offset:20992
    ds_read_b64_tr_b16 v[52:53], v23 offset:20480
    ds_read_b64_tr_b16 v[54:55], v23 offset:20992
    s_waitcnt lgkmcnt(0)
    v_mfma_f32_16x16x32_bf16 v[88:91], v[24:27], v[40:43], v[88:91]
    v_mfma_f32_16x16x32_bf16 v[92:95], v[24:27], v[44:47], v[92:95]
    v_mfma_f32_16x16x32_bf16 v[88:91], v[28:31], v[48:51], v[88:91]
    v_mfma_f32_16x16x32_bf16 v[92:95], v[28:31], v[52:55], v[92:95]
    ds_read_b128 v[32:35], v22 offset:384
    ds_read_b64_tr_b16 v[56:57], v21 offset:24576
    ds_read_b64_tr_b16 v[58:59], v21 offset:25088
    ds_read_b64_tr_b16 v[60:61], v23 offset:24576
    ds_read_b64_tr_b16 v[62:63], v23 offset:25088
    ds_read_b128 v[36:39], v22 offset:448
    ds_read_b64_tr_b16 v[64:65], v21 offset:28672
    ds_read_b64_tr_b16 v[66:67], v21 offset:29184
    ds_read_b64_tr_b16 v[68:69], v23 offset:28672
    ds_read_b64_tr_b16 v[70:71], v23 offset:29184
    s_waitcnt lgkmcnt(0)
    v_mfma_f32_16x16x32_bf16 v[88:91], v[32:35], v[56:59], v[88:91]
    v_mfma_f32_16x16x32_bf16 v[92:95], v[32:35], v[60:63], v[92:95]
    v_mfma_f32_16x16x32_bf16 v[88:91], v[36:39], v[64:67], v[88:91]
    v_mfma_f32_16x16x32_bf16 v[92:95], v[36:39], v[68:71], v[92:95]
    v_readfirstlane_b32 s68, v6
    v_readfirstlane_b32 s69, v7
    s_cmp_eq_u32 s6, 1
    s_cselect_b32 s8, s69, s68
    s_cmp_eq_u32 s3, 1
    s_cselect_b32 s11, s69, s68
    s_mov_b32 s60, 0xffff
    s_mov_b32 s61, 0xffff
    s_mov_b32 s62, 0xffffffff
    s_mov_b32 s63, 0x0
    s_cmp_eq_u32 s95, 1
    s_cselect_b32 s55, s69, s68
    s_lshl_b32 s53, s95, 16
    s_lshl_b32 s54, s42, 14
    s_add_u32 s53, s53, s54
    s_lshl_b32 s54, s52, 1
    s_add_u32 s53, s53, s54
    s_lshl_b32 s54, s3, 7
    s_add_u32 s53, s53, s54
    s_add_u32 s53, s53, 65536
    s_add_u32 s54, s53, 16777216
    s_and_b32 s55, s55, 0xff
    s_mov_b32 s56, 0xffffff00
    v_and_b32 v23, 15, v0
    v_lshlrev_b32 v23, 2, v23
    v_bfe_u32 v24, v0, 4, 1
    v_lshl_add_u32 v23, v24, 15, v23
    v_lshrrev_b32 v24, 5, v0
    v_lshl_add_u32 v23, v24, 6, v23
    v_mov_b32 v27, s55
    v_cndmask_b32 v24, v89, v88, s[60:61]
    v_cndmask_b32 v25, v93, v92, s[60:61]
    v_cndmask_b32 v26, v25, v24, s[62:63]
    v_and_or_b32 v26, v26, s56, v27
    buffer_store_dword v26, v23, s[12:15], s53 offen
    buffer_store_dword v26, v23, s[12:15], s54 offen sc1
    s_cmp_eq_u32 s7, 12
    s_cbranch_scc1 L_39
    s_cmp_gt_u32 s7, 12
    s_cselect_b32 s53, 1, 0
    s_cmp_lg_u32 s53, s3
    s_cbranch_scc1 L_38
L_39:
    s_lshl_b32 s53, s3, 1
    s_add_u32 s53, s53, s6
    s_lshl_b32 s53, s53, 15
    s_lshl_b32 s54, s4, 11
    s_add_u32 s53, s53, s54
    s_add_u32 s53, s53, 65536
    s_and_b32 s11, s11, 0xff
    s_mul_i32 s11, s11, 0x01010101
    v_mov_b32 v58, 0x0c0c0400
    v_mov_b32 v59, 0x04000c0c
    s_mov_b32 s10, 0x8000
    s_sleep 56
P_40:
    s_sleep 4
    s_cmp_lt_u32 s10, 32767
    s_cselect_b32 s55, s10, 0
    s_and_b32 s55, s55, 1
    s_mul_i32 s55, s55, 16777216
    s_add_u32 s55, s55, s53
    s_add_u32 s54, s55, 0x4000
    buffer_load_dwordx4 v[24:27], v2, s[12:15], s55 offen offset:0 sc1
    buffer_load_dwordx4 v[32:35], v2, s[12:15], s54 offen offset:0 sc1
    buffer_load_dwordx4 v[28:31], v2, s[12:15], s55 offen offset:1024 sc1
    buffer_load_dwordx4 v[36:39], v2, s[12:15], s54 offen offset:1024 sc1
    s_waitcnt vmcnt(0)
    v_perm_b32 v40, v25, v24, v58
    v_perm_b32 v41, v27, v26, v59
    v_or_b32 v40, v40, v41
    v_perm_b32 v42, v29, v28, v58
    v_perm_b32 v43, v31, v30, v59
    v_or_b32 v42, v42, v43
    v_perm_b32 v44, v33, v32, v58
    v_perm_b32 v45, v35, v34, v59
    v_or_b32 v44, v44, v45
    v_perm_b32 v46, v37, v36, v58
    v_perm_b32 v47, v39, v38, v59
    v_or_b32 v46, v46, v47
    v_min_u32 v56, v40, v42
    v_max_u32 v57, v40, v42
    v_min3_u32 v56, v56, v44, v46
    v_max3_u32 v57, v57, v44, v46
    v_cmp_eq_u32 vcc, s11, v56
    v_cmp_eq_u32 s[60:61], s11, v57
    s_and_b64 vcc, vcc, s[60:61]
    s_cmp_eq_u64 vcc, -1
    s_cbranch_scc1 P_41
    s_sub_u32 s10, s10, 1
    s_cmp_lg_u32 s10, 0
    s_cbranch_scc1 P_40
P_41:
    v_lshlrev_b32 v23, 3, v0
    s_lshl_b32 s54, s3, 10
    s_add_u32 s54, s54, 67584
    v_add_u32 v23, s54, v23
    v_and_b32 v24, 0xffffff00, v24
    v_and_b32 v25, 0xffffff00, v25
    v_and_b32 v26, 0xffffff00, v26
    v_and_b32 v27, 0xffffff00, v27
    v_and_b32 v28, 0xffffff00, v28
    v_and_b32 v29, 0xffffff00, v29
    v_and_b32 v30, 0xffffff00, v30
    v_and_b32 v31, 0xffffff00, v31
    v_and_b32 v32, 0xffffff00, v32
    v_and_b32 v33, 0xffffff00, v33
    v_and_b32 v34, 0xffffff00, v34
    v_and_b32 v35, 0xffffff00, v35
    v_and_b32 v36, 0xffffff00, v36
    v_and_b32 v37, 0xffffff00, v37
    v_and_b32 v38, 0xffffff00, v38
    v_and_b32 v39, 0xffffff00, v39
    v_add_f32 v24, v24, v32
    v_add_f32 v25, v25, v33
    v_add_f32 v26, v26, v34
    v_add_f32 v27, v27, v35
    v_cvt_pk_bf16_f32 v24, v24, v25
    v_cvt_pk_bf16_f32 v25, v26, v27
    ds_write_b64 v23, v[24:25] offset:0
    v_add_f32 v28, v28, v36
    v_add_f32 v29, v29, v37
    v_add_f32 v30, v30, v38
    v_add_f32 v31, v31, v39
    v_cvt_pk_bf16_f32 v28, v28, v29
    v_cvt_pk_bf16_f32 v29, v30, v31
    ds_write_b64 v23, v[28:29] offset:512
    s_lshl_b32 s54, s3, 2
    v_add_u32 v23, s54, v4
    ds_write_b32 v23, v5 offset:4
L_38:
    v_lshrrev_b32 v18, 4, v0
    v_bfe_u32 v19, v0, 1, 3
    v_xor_b32 v19, v19, v18
    v_lshlrev_b32 v20, 10, v18
    v_lshl_add_u32 v20, v19, 5, v20
    v_and_b32 v19, 1, v0
    v_lshl_add_u32 v20, v19, 4, v20
    v_xor_b32 v21, 0x80, v20
    s_and_b32 s52, s7, 3
    s_lshr_b32 s53, s7, 2
    s_lshl_b32 s54, s4, 2
    s_add_u32 s54, s54, s53
    s_lshl_b32 s54, s54, 17
    s_lshl_b32 s55, s52, 8
    s_add_u32 s54, s54, s55
    s_lshl_b32 s55, s3, 16
    s_add_u32 s54, s54, s55
    s_lshl_b32 s55, s3, 14
    s_add_u32 s55, s55, 32768
    s_mov_b32 s10, 1048576
W_42:
    ds_read_b32 v6, v4 offset:40
    s_waitcnt lgkmcnt(0)
    v_readfirstlane_b32 s9, v6
    s_cmp_ge_u32 s9, 4
    s_cbranch_scc1 W_43
    s_sleep 2
    s_sub_u32 s10, s10, 1
    s_cmp_lg_u32 s10, 0
    s_cbranch_scc1 W_42
W_43:
    s_mov_b32 m0, s55
    s_add_u32 s55, s55, 1024
    buffer_load_dwordx4 v20, s[64:67], s54 offen nt lds
    s_add_u32 s54, s54, 0x1000
    s_mov_b32 m0, s55
    s_add_u32 s55, s55, 1024
    buffer_load_dwordx4 v20, s[64:67], s54 offen nt lds
    s_add_u32 s54, s54, 0x1000
    s_mov_b32 m0, s55
    s_add_u32 s55, s55, 1024
    buffer_load_dwordx4 v21, s[64:67], s54 offen nt lds
    s_add_u32 s54, s54, 0x1000
    s_mov_b32 m0, s55
    s_add_u32 s55, s55, 1024
    buffer_load_dwordx4 v21, s[64:67], s54 offen nt lds
    s_add_u32 s54, s54, 0x1000
    s_mov_b32 m0, s55
    s_add_u32 s55, s55, 1024
    buffer_load_dwordx4 v20, s[64:67], s54 offen nt lds
    s_add_u32 s54, s54, 0x1000
    s_mov_b32 m0, s55
    s_add_u32 s55, s55, 1024
    buffer_load_dwordx4 v20, s[64:67], s54 offen nt lds
    s_add_u32 s54, s54, 0x1000
    s_mov_b32 m0, s55
    s_add_u32 s55, s55, 1024
    buffer_load_dwordx4 v21, s[64:67], s54 offen nt lds
    s_add_u32 s54, s54, 0x1000
    s_mov_b32 m0, s55
    s_add_u32 s55, s55, 1024
    buffer_load_dwordx4 v21, s[64:67], s54 offen nt lds
    s_add_u32 s54, s54, 0x1000
    s_mov_b32 m0, s55
    s_add_u32 s55, s55, 1024
    buffer_load_dwordx4 v20, s[64:67], s54 offen nt lds
    s_add_u32 s54, s54, 0x1000
    s_mov_b32 m0, s55
    s_add_u32 s55, s55, 1024
    buffer_load_dwordx4 v20, s[64:67], s54 offen nt lds
    s_add_u32 s54, s54, 0x1000
    s_mov_b32 m0, s55
    s_add_u32 s55, s55, 1024
    buffer_load_dwordx4 v21, s[64:67], s54 offen nt lds
    s_add_u32 s54, s54, 0x1000
    s_mov_b32 m0, s55
    s_add_u32 s55, s55, 1024
    buffer_load_dwordx4 v21, s[64:67], s54 offen nt lds
    s_add_u32 s54, s54, 0x1000
    s_mov_b32 m0, s55
    s_add_u32 s55, s55, 1024
    buffer_load_dwordx4 v20, s[64:67], s54 offen nt lds
    s_add_u32 s54, s54, 0x1000
    s_mov_b32 m0, s55
    s_add_u32 s55, s55, 1024
    buffer_load_dwordx4 v20, s[64:67], s54 offen nt lds
    s_add_u32 s54, s54, 0x1000
    s_mov_b32 m0, s55
    s_add_u32 s55, s55, 1024
    buffer_load_dwordx4 v21, s[64:67], s54 offen nt lds
    s_add_u32 s54, s54, 0x1000
    s_mov_b32 m0, s55
    s_add_u32 s55, s55, 1024
    buffer_load_dwordx4 v21, s[64:67], s54 offen nt lds
    s_mov_b64 exec, 1
    ds_add_u32 v4, v5 offset:48
    s_mov_b64 exec, -1
    s_waitcnt vmcnt(0)
    s_mov_b64 exec, 1
    ds_add_u32 v4, v5 offset:44
    s_mov_b64 exec, -1
    s_mov_b32 s43, s3
    s_branch L_kv_proj
L_gather:
    s_and_b32 s52, s42, 1
    s_lshr_b32 s53, s7, 2
    v_lshrrev_b32 v22, 5, v0
    v_and_b32 v23, 31, v0
    v_lshlrev_b32 v23, 4, v23
    v_lshlrev_b32 v24, 4, v0
    s_cmp_eq_u32 s6, 1
    s_cselect_b32 s56, 3, 12
    v_and_b32 v25, 15, v0
    v_cmp_ge_u32 s[58:59], s56, v25
    v_and_b32 v27, 1, v25
    v_lshlrev_b32 v27, 5, v27
    v_lshrrev_b32 v26, 1, v25
    v_lshl_add_u32 v27, v26, 2, v27
    s_lshl_b32 s9, s52, 6
    s_add_u32 s9, s9, 69632
    v_add_u32 v27, s9, v27
    v_lshlrev_b32 v21, 5, v22
    v_add_u32 v21, s9, v21
    v_min_u32 v25, s56, v25
    v_lshlrev_b32 v25, 7, v25
    v_lshrrev_b32 v26, 1, v23
    v_lshl_add_u32 v26, v22, 2, v26
    s_lshl_b32 s9, s52, 8
    s_add_u32 s9, s9, 99328
    v_add_u32 v26, s9, v26
    s_lshl_b32 s60, s52, 3
    s_add_u32 s60, s60, s4
    s_lshl_b32 s60, s60, 2
    s_add_u32 s60, s60, s53
    s_lshl_b32 s60, s60, 14
    s_add_u32 s60, s60, 524288
    s_mul_i32 s61, s6, 1664
    s_add_u32 s61, s61, s60
    s_add_u32 s61, s61, 12288
    s_mul_i32 s62, s6, 6656
    s_add_u32 s60, s60, s62
    s_and_b32 s62, s7, 3
    s_mul_i32 s63, s62, s6
    s_cmp_lg_u32 s63, 0
    s_cbranch_scc1 L_44
    s_lshl_b32 s62, s62, 11
    s_add_u32 s62, s62, s60
    buffer_load_dwordx4 v[32:35], v24, s[12:15], s62 offen sc1
    buffer_load_dwordx4 v[36:39], v24, s[12:15], s62 offen offset:1024 sc1
L_44:
    s_lshl_b32 s62, s2, 1
    s_add_u32 s62, s62, s52
    s_lshl_b32 s62, s62, 10
    s_add_u32 s62, s62, 1572864
    buffer_load_dwordx4 v[72:75], v24, s[12:15], s62 offen
    s_mov_b32 s57, 0
    s_mov_b32 s10, 1048576
W_45:
    ds_read_b32 v6, v4 offset:16
    s_waitcnt lgkmcnt(0)
    v_readfirstlane_b32 s9, v6
    s_cmp_ge_u32 s9, 10
    s_cbranch_scc1 W_46
    s_sleep 2
    s_sub_u32 s10, s10, 1
    s_cmp_lg_u32 s10, 0
    s_cbranch_scc1 W_45
W_46:
P_47:
    buffer_load_dwordx4 v[60:63], v25, s[12:15], s61 offen sc1
    s_waitcnt vmcnt(0)
    v_cmp_eq_u32 vcc, s8, v61
    v_cmp_eq_u32 s[62:63], s8, v63
    s_and_b64 vcc, vcc, s[62:63]
    s_cmp_eq_u64 vcc, -1
    s_cbranch_scc1 P_48
    ds_read_b32 v6, v4 offset:48
    s_waitcnt lgkmcnt(0)
    v_readfirstlane_b32 s9, v6
    s_cmp_ge_u32 s9, 2
    s_cbranch_scc1 P_49
    s_sleep 4
    s_branch P_47
P_48:
    v_mov_b32 v28, v60
    s_nop 1
    v_max_f32_dpp v28, v28, v28 row_ror:8 row_mask:0xf bank_mask:0xf
    s_nop 1
    v_max_f32_dpp v28, v28, v28 row_ror:4 row_mask:0xf bank_mask:0xf
    s_nop 1
    v_max_f32_dpp v28, v28, v28 row_ror:2 row_mask:0xf bank_mask:0xf
    s_nop 1
    v_max_f32_dpp v28, v28, v28 row_ror:1 row_mask:0xf bank_mask:0xf
    v_sub_f32 v60, v60, v28
    v_exp_f32 v60, v60
    s_nop 0
    v_cndmask_b32 v60, 0, v60, s[58:59]
    v_mul_f32 v29, v60, v62
    s_nop 1
    v_add_f32_dpp v29, v29, v29 row_ror:8 row_mask:0xf bank_mask:0xf
    s_nop 1
    v_add_f32_dpp v29, v29, v29 row_ror:4 row_mask:0xf bank_mask:0xf
    s_nop 1
    v_add_f32_dpp v29, v29, v29 row_ror:2 row_mask:0xf bank_mask:0xf
    s_nop 1
    v_add_f32_dpp v29, v29, v29 row_ror:1 row_mask:0xf bank_mask:0xf
    v_rcp_f32 v29, v29
    s_nop 0
    v_mul_f32 v60, v60, v29
    ds_write_b32 v27, v60
    ds_read_b128 v[64:67], v21
    ds_read_b128 v[68:71], v21 offset:16
    s_mov_b32 s57, 1
    s_mov_b32 s10, 1048576
W_50:
    ds_read_b32 v6, v4 offset:48
    s_waitcnt lgkmcnt(0)
    v_readfirstlane_b32 s9, v6
    s_cmp_ge_u32 s9, 2
    s_cbranch_scc1 W_51
    s_sleep 1
    s_sub_u32 s10, s10, 1
    s_cmp_lg_u32 s10, 0
    s_cbranch_scc1 W_50
W_51:
P_49:
    s_cmp_eq_u32 s6, 1
    s_cbranch_scc1 L_52
    s_mov_b32 s10, 0x8000
P_53:
    s_cmp_lt_u32 s10, 32752
    s_cselect_b32 s55, s10, 0
    s_and_b32 s55, s55, 1
    s_mul_i32 s55, s55, 16777216
    s_add_u32 s62, s55, s60
    buffer_load_dwordx4 v[32:35], v24, s[12:15], s62 offen offset:0 sc1
    buffer_load_dwordx4 v[36:39], v24, s[12:15], s62 offen offset:1024 sc1
    buffer_load_dwordx4 v[40:43], v24, s[12:15], s62 offen offset:2048 sc1
    buffer_load_dwordx4 v[44:47], v24, s[12:15], s62 offen offset:3072 sc1
    s_add_u32 s62, s62, 0x1000
    buffer_load_dwordx4 v[48:51], v24, s[12:15], s62 offen offset:0 sc1
    buffer_load_dwordx4 v[52:55], v24, s[12:15], s62 offen offset:1024 sc1
    buffer_load_dwordx4 v[56:59], v23, s[12:15], s62 offen offset:2048 sc1
    s_cmp_lg_u32 s57, 0
    s_cbranch_scc1 P_54
    s_add_u32 s55, s55, s61
    buffer_load_dwordx4 v[60:63], v25, s[12:15], s55 offen sc1
    s_waitcnt vmcnt(0)
    v_cmp_eq_u32 vcc, s8, v61
    v_cmp_eq_u32 s[62:63], s8, v63
    s_and_b64 vcc, vcc, s[62:63]
    s_cmp_eq_u64 vcc, -1
    s_cbranch_scc0 P_55
    v_mov_b32 v28, v60
    s_nop 1
    v_max_f32_dpp v28, v28, v28 row_ror:8 row_mask:0xf bank_mask:0xf
    s_nop 1
    v_max_f32_dpp v28, v28, v28 row_ror:4 row_mask:0xf bank_mask:0xf
    s_nop 1
    v_max_f32_dpp v28, v28, v28 row_ror:2 row_mask:0xf bank_mask:0xf
    s_nop 1
    v_max_f32_dpp v28, v28, v28 row_ror:1 row_mask:0xf bank_mask:0xf
    v_sub_f32 v60, v60, v28
    v_exp_f32 v60, v60
    s_nop 0
    v_cndmask_b32 v60, 0, v60, s[58:59]
    v_mul_f32 v29, v60, v62
    s_nop 1
    v_add_f32_dpp v29, v29, v29 row_ror:8 row_mask:0xf bank_mask:0xf
    s_nop 1
    v_add_f32_dpp v29, v29, v29 row_ror:4 row_mask:0xf bank_mask:0xf
    s_nop 1
    v_add_f32_dpp v29, v29, v29 row_ror:2 row_mask:0xf bank_mask:0xf
    s_nop 1
    v_add_f32_dpp v29, v29, v29 row_ror:1 row_mask:0xf bank_mask:0xf
    v_rcp_f32 v29, v29
    s_nop 0
    v_mul_f32 v60, v60, v29
    ds_write_b32 v27, v60
    ds_read_b128 v[64:67], v21
    ds_read_b128 v[68:71], v21 offset:16
    s_mov_b32 s57, 1
P_54:
    s_waitcnt vmcnt(6)
    v_min_u32 v28, v33, v35
    v_max_u32 v29, v33, v35
    s_waitcnt vmcnt(5)
    v_min3_u32 v28, v28, v37, v39
    v_max3_u32 v29, v29, v37, v39
    s_waitcnt vmcnt(4)
    v_min3_u32 v28, v28, v41, v43
    v_max3_u32 v29, v29, v41, v43
    s_waitcnt vmcnt(3)
    v_min3_u32 v28, v28, v45, v47
    v_max3_u32 v29, v29, v45, v47
    s_waitcnt vmcnt(2)
    v_min3_u32 v28, v28, v49, v51
    v_max3_u32 v29, v29, v49, v51
    s_waitcnt vmcnt(1)
    v_min3_u32 v28, v28, v53, v55
    v_max3_u32 v29, v29, v53, v55
    s_waitcnt vmcnt(0)
    v_min3_u32 v28, v28, v57, v59
    v_max3_u32 v29, v29, v57, v59
    v_cmp_eq_u32 vcc, s8, v28
    v_cmp_eq_u32 s[62:63], s8, v29
    s_and_b64 vcc, vcc, s[62:63]
    s_cmp_eq_u64 vcc, -1
    s_cbranch_scc1 P_56
P_55:
    s_sub_u32 s10, s10, 1
    s_cmp_lg_u32 s10, 0
    s_cbranch_scc1 P_53
P_56:
L_gs_7:
    s_waitcnt lgkmcnt(0)
    v_lshlrev_b32 v33, 16, v32
    v_and_b32 v32, 0xffff0000, v32
    v_lshlrev_b32 v35, 16, v34
    v_and_b32 v34, 0xffff0000, v34
    v_mul_f32 v96, v64, v33
    v_mul_f32 v97, v64, v32
    v_mul_f32 v98, v64, v35
    v_mul_f32 v99, v64, v34
    v_lshlrev_b32 v37, 16, v36
    v_and_b32 v36, 0xffff0000, v36
    v_lshlrev_b32 v39, 16, v38
    v_and_b32 v38, 0xffff0000, v38
    v_fmac_f32 v96, v65, v37
    v_fmac_f32 v97, v65, v36
    v_fmac_f32 v98, v65, v39
    v_fmac_f32 v99, v65, v38
    v_lshlrev_b32 v41, 16, v40
    v_and_b32 v40, 0xffff0000, v40
    v_lshlrev_b32 v43, 16, v42
    v_and_b32 v42, 0xffff0000, v42
    v_fmac_f32 v96, v66, v41
    v_fmac_f32 v97, v66, v40
    v_fmac_f32 v98, v66, v43
    v_fmac_f32 v99, v66, v42
    v_lshlrev_b32 v45, 16, v44
    v_and_b32 v44, 0xffff0000, v44
    v_lshlrev_b32 v47, 16, v46
    v_and_b32 v46, 0xffff0000, v46
    v_fmac_f32 v96, v67, v45
    v_fmac_f32 v97, v67, v44
    v_fmac_f32 v98, v67, v47
    v_fmac_f32 v99, v67, v46
    v_lshlrev_b32 v49, 16, v48
    v_and_b32 v48, 0xffff0000, v48
    v_lshlrev_b32 v51, 16, v50
    v_and_b32 v50, 0xffff0000, v50
    v_fmac_f32 v96, v68, v49
    v_fmac_f32 v97, v68, v48
    v_fmac_f32 v98, v68, v51
    v_fmac_f32 v99, v68, v50
    v_lshlrev_b32 v53, 16, v52
    v_and_b32 v52, 0xffff0000, v52
    v_lshlrev_b32 v55, 16, v54
    v_and_b32 v54, 0xffff0000, v54
    v_fmac_f32 v96, v69, v53
    v_fmac_f32 v97, v69, v52
    v_fmac_f32 v98, v69, v55
    v_fmac_f32 v99, v69, v54
    v_lshlrev_b32 v57, 16, v56
    v_and_b32 v56, 0xffff0000, v56
    v_lshlrev_b32 v59, 16, v58
    v_and_b32 v58, 0xffff0000, v58
    v_fmac_f32 v96, v70, v57
    v_fmac_f32 v97, v70, v56
    v_fmac_f32 v98, v70, v59
    v_fmac_f32 v99, v70, v58
    s_nop 0
    s_branch L_g_fin
L_52:
    s_mov_b32 s10, 0x8000
P_57:
    s_cmp_lt_u32 s10, 32752
    s_cselect_b32 s55, s10, 0
    s_and_b32 s55, s55, 1
    s_mul_i32 s55, s55, 16777216
    s_add_u32 s62, s55, s60
    buffer_load_dwordx4 v[32:35], v24, s[12:15], s62 offen offset:0 sc1
    buffer_load_dwordx4 v[36:39], v24, s[12:15], s62 offen offset:1024 sc1
    s_cmp_lg_u32 s57, 0
    s_cbranch_scc1 P_58
    s_add_u32 s55, s55, s61
    buffer_load_dwordx4 v[60:63], v25, s[12:15], s55 offen sc1
    s_waitcnt vmcnt(0)
    v_cmp_eq_u32 vcc, s8, v61
    v_cmp_eq_u32 s[62:63], s8, v63
    s_and_b64 vcc, vcc, s[62:63]
    s_cmp_eq_u64 vcc, -1
    s_cbranch_scc0 P_59
    v_mov_b32 v28, v60
    s_nop 1
    v_max_f32_dpp v28, v28, v28 row_ror:8 row_mask:0xf bank_mask:0xf
    s_nop 1
    v_max_f32_dpp v28, v28, v28 row_ror:4 row_mask:0xf bank_mask:0xf
    s_nop 1
    v_max_f32_dpp v28, v28, v28 row_ror:2 row_mask:0xf bank_mask:0xf
    s_nop 1
    v_max_f32_dpp v28, v28, v28 row_ror:1 row_mask:0xf bank_mask:0xf
    v_sub_f32 v60, v60, v28
    v_exp_f32 v60, v60
    s_nop 0
    v_cndmask_b32 v60, 0, v60, s[58:59]
    v_mul_f32 v29, v60, v62
    s_nop 1
    v_add_f32_dpp v29, v29, v29 row_ror:8 row_mask:0xf bank_mask:0xf
    s_nop 1
    v_add_f32_dpp v29, v29, v29 row_ror:4 row_mask:0xf bank_mask:0xf
    s_nop 1
    v_add_f32_dpp v29, v29, v29 row_ror:2 row_mask:0xf bank_mask:0xf
    s_nop 1
    v_add_f32_dpp v29, v29, v29 row_ror:1 row_mask:0xf bank_mask:0xf
    v_rcp_f32 v29, v29
    s_nop 0
    v_mul_f32 v60, v60, v29
    ds_write_b32 v27, v60
    ds_read_b128 v[64:67], v21
    ds_read_b128 v[68:71], v21 offset:16
    s_mov_b32 s57, 1
P_58:
    s_waitcnt vmcnt(1)
    v_min_u32 v28, v33, v35
    v_max_u32 v29, v33, v35
    s_waitcnt vmcnt(0)
    v_min3_u32 v28, v28, v37, v39
    v_max3_u32 v29, v29, v37, v39
    v_cmp_eq_u32 vcc, s8, v28
    v_cmp_eq_u32 s[62:63], s8, v29
    s_and_b64 vcc, vcc, s[62:63]
    s_cmp_eq_u64 vcc, -1
    s_cbranch_scc1 P_60
P_59:
    s_sub_u32 s10, s10, 1
    s_cmp_lg_u32 s10, 0
    s_cbranch_scc1 P_57
P_60:
L_gs_2:
    s_waitcnt lgkmcnt(0)
    v_lshlrev_b32 v33, 16, v32
    v_and_b32 v32, 0xffff0000, v32
    v_lshlrev_b32 v35, 16, v34
    v_and_b32 v34, 0xffff0000, v34
    v_mul_f32 v96, v64, v33
    v_mul_f32 v97, v64, v32
    v_mul_f32 v98, v64, v35
    v_mul_f32 v99, v64, v34
    v_lshlrev_b32 v37, 16, v36
    v_and_b32 v36, 0xffff0000, v36
    v_lshlrev_b32 v39, 16, v38
    v_and_b32 v38, 0xffff0000, v38
    v_fmac_f32 v96, v65, v37
    v_fmac_f32 v97, v65, v36
    v_fmac_f32 v98, v65, v39
    v_fmac_f32 v99, v65, v38
    s_nop 0
    s_branch L_g_fin
L_g_fin:
    v_permlane32_swap_b32 v96, v98
    v_permlane32_swap_b32 v97, v99
    v_add_f32 v96, v96, v98
    v_add_f32 v97, v97, v99
    v_cvt_pk_bf16_f32 v96, v96, v97
    ds_write_b32 v26, v96
    s_mov_b64 exec, 1
    ds_add_u32 v4, v5 offset:24
    s_mov_b64 exec, -1
L_end:
    s_endpgm
.section .rodata,"a"
.p2align 6
.amdhsa_kernel concat_heads__gqa_block_cached__sliding_block_cached__decode_kernel
  .amdhsa_next_free_vgpr 168
  .amdhsa_next_free_sgpr 96
  .amdhsa_accum_offset 168
  .amdhsa_group_segment_fixed_size 0
  .amdhsa_kernarg_size 104
  .amdhsa_user_sgpr_count 2
  .amdhsa_user_sgpr_kernarg_segment_ptr 1
  .amdhsa_system_sgpr_workgroup_id_x 1
.end_amdhsa_kernel
```
